```python
import torch

def _softmax(x, axis=-1):
    return torch.softmax(x, dim=axis)
def _gelu(x):
    return torch.nn.functional.gelu(x, approximate="tanh")
def _silu(x):
    return torch.nn.functional.silu(x)
def _sigmoid(x):
    return torch.sigmoid(x)
def _layernorm(x, axis=-1, eps=1e-5):
    m = x.mean(dim=axis, keepdim=True)
    v = x.var(dim=axis, keepdim=True, unbiased=False)
    return (x - m) / torch.sqrt(v + eps)
def _scatter_add(tgt, idx, src, axis=0):
    return tgt.clone().index_add_(axis, idx, src)
def _segment_sum(src, seg, n):
    out = torch.zeros((n,) + src.shape[1:], dtype=src.dtype)
    return out.index_add_(0, seg, src)
def _pad(x, pw):
    flat = tuple(v for pair in reversed(pw) for v in pair)
    return torch.nn.functional.pad(x, flat)

kernel_name = 'standalone__paged_block_table_kv_radixattention__decode'

def setup_inputs():

    _w = (lambda a: (lambda t: t.to(torch.bfloat16) if t.is_floating_point() else t)(torch.as_tensor(a)))
    B, H, Hkv, Dh = 4, 32, 8, 128
    Lk = 16384
    bs = 16
    nb = max(2, Lk // bs)
    P = max(1, nb // 2)
    n_phys = P + B * (nb - P)
    shared = torch.arange(P, dtype=torch.int64)
    priv = P + torch.arange(B * (nb - P), dtype=torch.int64).reshape(B, nb - P)
    bt = torch.cat([torch.tile(shared[None, :], (B, 1)), priv], dim=1)
    ctx = nb * bs - (torch.arange(1, B + 1, dtype=torch.int64) * 2654435761) % max(1, (nb * bs - P * bs) // 2)
    return {
        "q": _w((lambda *s: torch.randn(*s, dtype=torch.bfloat16) * 0.8)(B, H, Dh)),
        "k_cache": _w((lambda *s: torch.randn(*s, dtype=torch.bfloat16) * 0.8)(n_phys, bs, Hkv, Dh)),
        "v_cache": _w((lambda *s: torch.randn(*s, dtype=torch.bfloat16) * 0.05)(n_phys, bs, Hkv, Dh)),
        "block_table": _w(bt.to(torch.int64)),
        "ctx_lens": _w(torch.as_tensor(ctx).to(torch.int64)),
    }

def reference(q, k_cache, v_cache, block_table, ctx_lens):
    B, H, Dh = q.shape
    n_phys, bs, Hkv, _ = k_cache.shape
    nb = block_table.shape[1]
    Lk = nb * bs
    rep = H // Hkv
    k = k_cache[block_table].reshape(B, Lk, Hkv, Dh)
    v = v_cache[block_table].reshape(B, Lk, Hkv, Dh)
    k = (lambda x, n, axis: torch.repeat_interleave(x, n, dim=axis))(k, rep, axis=2)
    v = (lambda x, n, axis: torch.repeat_interleave(x, n, dim=axis))(v, rep, axis=2)
    scores = torch.einsum("bhd,bkhd->bhk", q, k) * (Dh ** -0.5)
    pos = torch.arange(Lk)
    valid = pos[None, :] < ctx_lens[:, None]
    scores = torch.where(valid[:, None, :], scores, -1e9)
    p = _softmax(scores, axis=-1)
    return torch.einsum("bhk,bkhd->bhd", p, v)
```

```asm
; @launch grid=(256,1,1) block=(320,1,1) lds=49984
.amdgcn_target "amdgcn-amd-amdhsa--gfx950"
.text
.globl standalone__paged_block_table_kv_radixattention__decode_kernel
.p2align 8
.type standalone__paged_block_table_kv_radixattention__decode_kernel,@function
standalone__paged_block_table_kv_radixattention__decode_kernel:
  s_cmp_ge_u32 s2, 256
  s_cbranch_scc1 L_end
  s_load_dwordx16 s[4:19], s[0:1], 0
  s_getpc_b64 s[40:41]
L_pc:
  v_lshlrev_b32 v29, 4, v0
  s_mov_b32 s42, L_codeend-L_pc
  s_mov_b32 s43, 0x20000
  s_movk_i32 s78, 0x1400
  buffer_load_dwordx4 v[164:167], v29, s[40:43], 0 offen
  buffer_load_dwordx4 v[160:163], v29, s[40:43], s78 offen
  v_and_b32 v1, 63, v0
  v_lshrrev_b32 v30, 6, v0
  v_lshrrev_b32 v2, 4, v1
  v_readfirstlane_b32 s52, v30
  v_and_b32 v3, 15, v0
  s_and_b32 s53, s2, 3
  s_lshr_b32 s54, s2, 2
  s_and_b32 s55, s52, 1
  s_lshr_b32 s56, s52, 1
  s_lshl_b32 s79, s53, 1
  s_add_u32 s79, s79, s55
  s_lshl_b32 s60, s52, 13
  s_movk_i32 s75, 0x1000
  s_movk_i32 s76, 0x2000
  s_movk_i32 s77, 0x3000
  v_lshrrev_b32 v25, 2, v3
  v_lshlrev_b32 v30, 13, v25
  v_and_b32 v26, 3, v3
  v_lshl_add_u32 v30, v26, 8, v30
  v_lshl_add_u32 v30, v2, 4, v30
  s_lshl_b32 s78, s79, 10
  v_add_u32 v30, s78, v30
  s_movk_i32 s34, 0x4000
  s_mov_b32 s35, 0x20000
  s_mov_b32 s30, 0x8000
  s_mov_b32 s31, 0x20000
  s_cmp_eq_u32 s52, 4
  s_waitcnt lgkmcnt(0)
  s_mov_b32 s32, s10
  s_mov_b32 s33, s11
  s_cbranch_scc1 L_hskip
  buffer_load_dwordx4 v[84:87], v29, s[32:35], 0 offen
  buffer_load_dwordx4 v[88:91], v29, s[32:35], s75 offen
  buffer_load_dwordx4 v[92:95], v29, s[32:35], s76 offen
  buffer_load_dwordx4 v[96:99], v29, s[32:35], s77 offen
  s_mov_b32 s28, s4
  s_mov_b32 s29, s5
  buffer_load_dwordx4 v[36:39], v30, s[28:31], 0 offen offset:0
  buffer_load_dwordx4 v[40:43], v30, s[28:31], 0 offen offset:64
  buffer_load_dwordx4 v[44:47], v30, s[28:31], 0 offen offset:128
  buffer_load_dwordx4 v[48:51], v30, s[28:31], 0 offen offset:192
L_hskip:
  s_load_dwordx4 s[48:51], s[12:13], 0
  s_mov_b32 s44, s16
  s_mov_b32 s45, s17
  s_mov_b32 s46, 0x100
  s_mov_b32 s47, 0x20000
  s_mov_b32 s20, s6
  s_mov_b32 s21, s7
  s_mov_b32 s22, 0x5000000
  s_mov_b32 s23, 0x20000
  s_mov_b32 s24, s8
  s_mov_b32 s25, s9
  s_mov_b32 s26, 0x5000000
  s_mov_b32 s27, 0x20000
  s_mov_b32 s36, s18
  s_mov_b32 s37, s19
  s_mov_b32 s38, 0x14000000
  s_mov_b32 s39, 0x20000
  s_mov_b32 s40, s14
  s_mov_b32 s41, s15
  s_mov_b32 s42, 0x8000
  s_mov_b32 s43, 0x20000
  s_lshl_b32 s80, s2, 3
  s_or_b32 s80, s80, s52
  s_cmp_eq_u32 s80, 4
  s_cbranch_scc1 L_mknon
L_nonon:
  s_mov_b32 s57, 0x3e0293ee
  s_mov_b32 s58, 0x05040100
  s_mov_b32 s59, 0x07060302
  s_lshl_b32 s78, s79, 8
  v_add_u32 v25, 0, v2
  v_xor_b32 v26, v25, v3
  v_lshlrev_b32 v26, 4, v26
  v_lshl_add_u32 v4, v25, 11, v26
  v_add_u32 v4, s78, v4
  v_lshl_add_u32 v10, v3, 8, v26
  v_add_u32 v10, s60, v10
  v_add_u32 v25, 4, v2
  v_xor_b32 v26, v25, v3
  v_lshlrev_b32 v26, 4, v26
  v_lshl_add_u32 v5, v25, 11, v26
  v_add_u32 v5, s78, v5
  v_subrev_u32 v5, 1024, v5
  v_lshl_add_u32 v11, v3, 8, v26
  v_add_u32 v11, s60, v11
  v_add_u32 v25, 8, v2
  v_xor_b32 v26, v25, v3
  v_lshlrev_b32 v26, 4, v26
  v_lshl_add_u32 v6, v25, 11, v26
  v_add_u32 v6, s78, v6
  v_subrev_u32 v6, 2048, v6
  v_lshl_add_u32 v12, v3, 8, v26
  v_add_u32 v12, s60, v12
  v_add_u32 v25, 12, v2
  v_xor_b32 v26, v25, v3
  v_lshlrev_b32 v26, 4, v26
  v_lshl_add_u32 v7, v25, 11, v26
  v_add_u32 v7, s78, v7
  v_subrev_u32 v7, 3072, v7
  v_lshl_add_u32 v13, v3, 8, v26
  v_add_u32 v13, s60, v13
  v_lshlrev_b32 v25, 13, v2
  v_lshl_add_u32 v8, v3, 4, v25
  v_add_u32 v8, s78, v8
  v_add_u32 v9, 0x1000, v8
  s_lshl_b32 s80, s52, 2
  v_mov_b32 v31, s80
  v_mov_b32 v32, 0
  v_lshlrev_b32 v17, 1, v1
  v_add_u32 v17, s56, v17
  v_lshlrev_b32 v17, 1, v17
  s_lshl_b32 s69, s56, 1
  v_mov_b32 v33, s69
  s_waitcnt lgkmcnt(0)
  s_mov_b32 s68, 0
  s_cmp_lt_i32 s48, 1
  s_cselect_b32 s79, 1, 0
  s_cselect_b32 s48, 0x4000, s48
  s_or_b32 s68, s68, s79
  s_min_u32 s48, s48, 0x4000
  s_add_u32 s62, s48, 15
  s_lshr_b32 s62, s62, 4
  s_cmp_lt_i32 s49, 1
  s_cselect_b32 s79, 2, 0
  s_cselect_b32 s49, 0x4000, s49
  s_or_b32 s68, s68, s79
  s_min_u32 s49, s49, 0x4000
  s_add_u32 s63, s49, 15
  s_lshr_b32 s63, s63, 4
  s_cmp_lt_i32 s50, 1
  s_cselect_b32 s79, 4, 0
  s_cselect_b32 s50, 0x4000, s50
  s_or_b32 s68, s68, s79
  s_min_u32 s50, s50, 0x4000
  s_add_u32 s64, s50, 15
  s_lshr_b32 s64, s64, 4
  s_cmp_lt_i32 s51, 1
  s_cselect_b32 s79, 8, 0
  s_cselect_b32 s51, 0x4000, s51
  s_or_b32 s68, s68, s79
  s_min_u32 s51, s51, 0x4000
  s_add_u32 s65, s51, 15
  s_lshr_b32 s65, s65, 4
  s_add_u32 s66, s62, s63
  s_add_u32 s67, s64, s65
  s_add_u32 s66, s66, s67
  s_add_u32 s66, s66, 63
  s_min_u32 s79, s48, s49
  s_min_u32 s80, s50, s51
  s_min_u32 s79, s79, s80
  s_lshr_b32 s79, s79, 6
  s_lshl_b32 s82, s52, 6
  s_cmp_eq_u32 s52, 4
  s_cbranch_scc1 L_bar1
  s_waitcnt vmcnt(4)
  v_cmp_ne_u64 s[4:5], v[84:85], v[88:89]
  v_cmp_ne_u64 s[6:7], v[86:87], v[90:91]
  v_cmp_ne_u64 s[8:9], v[84:85], v[92:93]
  v_cmp_ne_u64 s[10:11], v[86:87], v[94:95]
  v_cmp_ne_u64 s[12:13], v[84:85], v[96:97]
  v_cmp_ne_u64 s[14:15], v[86:87], v[98:99]
  ds_write_b128 v29, v[84:87] offset:33600
  s_or_b64 s[4:5], s[4:5], s[6:7]
  s_or_b64 s[8:9], s[8:9], s[10:11]
  s_or_b64 s[12:13], s[12:13], s[14:15]
  s_or_b64 s[4:5], s[4:5], s[8:9]
  s_or_b64 s[4:5], s[4:5], s[12:13]
  s_ff1_i32_b64 s75, s[4:5]
  s_cselect_b32 s80, s82, 0x401
  s_add_u32 s80, s80, s75
  v_mov_b32 v25, s80
  ds_write_b32 v31, v25 offset:33280
  ds_write_b128 v29, v[88:91] offset:37696
  ds_write_b128 v29, v[92:95] offset:41792
  ds_write_b128 v29, v[96:99] offset:45888
  s_waitcnt lgkmcnt(0)
L_bar1:
  s_barrier
  ds_read_b128 v[100:103], v32 offset:33280
  s_waitcnt lgkmcnt(0)
  v_min3_u32 v25, v100, v101, v102
  v_min3_u32 v25, v25, v103, s79
  s_nop 0
  v_readfirstlane_b32 s61, v25
  s_nop 0
  s_mul_i32 s81, s61, 12
  s_lshl_b32 s61, s61, 2
  s_sub_u32 s97, s66, s81
  s_lshr_b32 s95, s97, 6
  s_sub_u32 s81, 0, s95
  s_and_b32 s82, s95, s81
  s_max_u32 s82, s82, 4
  s_cmp_eq_u32 s82, s95
  s_cselect_b32 s81, s81, 0
  s_ff1_i32_b32 s70, s95
  s_and_b32 s28, s61, s81
  s_sub_u32 s62, s62, s61
  s_and_b32 s29, s62, s81
  s_sub_u32 s63, s63, s61
  s_and_b32 s30, s63, s81
  s_sub_u32 s64, s64, s61
  s_and_b32 s31, s64, s81
  s_sub_u32 s65, s65, s61
  s_and_b32 s98, s65, s81
  s_add_u32 s73, s28, s29
  s_add_u32 s74, s73, s30
  s_add_u32 s71, s74, s31
  s_add_u32 s96, s71, s98
  s_mul_i32 s66, s54, s95
  s_cmp_eq_u32 s52, 4
  s_cbranch_scc1 L_masks
  s_cmp_ge_u32 s66, s96
  s_cbranch_scc1 L_rem
  s_mov_b32 s77, 0
  s_mov_b32 s78, 0
  s_mov_b32 s79, s28
  s_mov_b32 s82, 0xffff
  s_cmp_ge_u32 s66, s28
  s_cselect_b32 s78, s28, s78
  s_cselect_b32 s79, s29, s79
  s_cselect_b32 s82, 15, s82
  s_cselect_b32 s69, s61, 0
  s_cmp_ge_u32 s66, s73
  s_cselect_b32 s77, 1024, s77
  s_cselect_b32 s78, s73, s78
  s_cselect_b32 s79, s30, s79
  s_cselect_b32 s82, 0xf0, s82
  s_cmp_ge_u32 s66, s74
  s_cselect_b32 s77, 2048, s77
  s_cselect_b32 s78, s74, s78
  s_cselect_b32 s79, s31, s79
  s_cselect_b32 s82, 0xf00, s82
  s_cmp_ge_u32 s66, s71
  s_cselect_b32 s77, 3072, s77
  s_cselect_b32 s78, s71, s78
  s_cselect_b32 s79, s98, s79
  s_cselect_b32 s82, 0xf000, s82
  s_sub_u32 s78, s66, s78
  s_sub_u32 s70, s70, 2
  s_lshr_b32 s78, s78, s70
  s_lshr_b32 s79, s79, s70
  s_add_u32 s77, s77, s69
  s_add_u32 s77, s77, s78
  v_mul_u32_u24 v25, s79, v1
  v_add3_u32 v25, v25, s77, v33
  v_lshlrev_b32 v23, 2, v25
  v_add_u32 v23, 0x8340, v23
  ds_read2_b32 v[14:15], v23 offset0:0 offset1:1
  v_cmp_gt_u32 s[88:89], s95, v17
  v_add_u32 v26, 1, v25
  v_mov_b32 v28, s82
  s_mov_b64 s[84:85], s[88:89]
  v_cndmask_b32 v27, 0, v28, s[88:89]
  v_cndmask_b32 v28, 0, v28, s[88:89]
L_desc:
  s_bitcmp1_b32 s88, 0
  s_cselect_b32 s77, 0x5000000, 0
  s_bitcmp1_b32 s84, 0
  s_cselect_b32 s78, 0x5000000, 0
  s_mov_b32 m0, s60
  s_mov_b32 s22, s77
  s_waitcnt lgkmcnt(0)
  v_readfirstlane_b32 s75, v14
  v_readfirstlane_b32 s76, v15
  v_min_u32 v14, 0x9ff, v14
  v_min_u32 v15, 0x9ff, v15
  s_min_u32 s75, s75, 0x9ff
  s_lshl_b32 s75, s75, 15
  buffer_load_dwordx4 v4, s[20:23], s75 offen offset:0 nt lds
  buffer_load_dwordx4 v5, s[20:23], s75 offen offset:1024 nt lds
  buffer_load_dwordx4 v6, s[20:23], s75 offen offset:2048 nt lds
  buffer_load_dwordx4 v7, s[20:23], s75 offen offset:3072 nt lds
  s_min_u32 s76, s76, 0x9ff
  s_lshl_b32 s76, s76, 15
  s_add_u32 m0, s60, 4096
  s_mov_b32 s22, s78
  buffer_load_dwordx4 v4, s[20:23], s76 offen offset:0 nt lds
  buffer_load_dwordx4 v5, s[20:23], s76 offen offset:1024 nt lds
  buffer_load_dwordx4 v6, s[20:23], s76 offen offset:2048 nt lds
  buffer_load_dwordx4 v7, s[20:23], s76 offen offset:3072 nt lds
  s_mov_b32 s26, s77
  buffer_load_dwordx4 v[136:139], v8, s[24:27], s75 offen offset:0 nt
  buffer_load_dwordx4 v[140:143], v8, s[24:27], s75 offen offset:2048 nt
  buffer_load_dwordx4 v[144:147], v9, s[24:27], s75 offen offset:0 nt
  buffer_load_dwordx4 v[148:151], v9, s[24:27], s75 offen offset:2048 nt
  s_mov_b32 s26, s78
  buffer_load_dwordx4 v[152:155], v8, s[24:27], s76 offen offset:0 nt
  buffer_load_dwordx4 v[156:159], v8, s[24:27], s76 offen offset:2048 nt
  buffer_load_dwordx4 v[160:163], v9, s[24:27], s76 offen offset:0 nt
  buffer_load_dwordx4 v[164:167], v9, s[24:27], s76 offen offset:2048 nt
  s_bcnt1_i32_b64 s70, s[88:89]
  v_lshlrev_b32 v14, 15, v14
  v_lshlrev_b32 v15, 15, v15
  v_and_b32 v16, 0x3ff, v25
  v_lshlrev_b32 v16, 4, v16
  v_lshl_or_b32 v16, v27, 16, v16
  v_and_b32 v17, 0x3ff, v26
  v_lshlrev_b32 v17, 4, v17
  v_lshl_or_b32 v17, v28, 16, v17
L_masks:
  s_sub_u32 s97, s97, 63
  s_ff1_i32_b32 s100, s95
  s_lshr_b32 s100, s96, s100
  s_sub_u32 s99, 64, s100
  v_cvt_f32_u32 v23, s99
  s_add_u32 s99, s99, s97
  s_sub_u32 s99, s99, s96
  s_lshl_b32 s99, s99, 1
  s_sub_u32 s99, s99, 1
  v_rcp_f32 v23, v23
  v_cvt_f32_u32 v24, s99
  v_mul_f32 v23, 0.5, v23
  v_mul_f32 v23, v23, v24
  v_cvt_u32_f32 v23, v23
  s_nop 0
  v_readfirstlane_b32 s99, v23
  v_mul_u32_u24 v25, s95, v1
  v_add_u32 v26, s95, v25
  v_subrev_u32 v23, s100, v1
  v_cmp_gt_u32 vcc, s100, v1
  v_mul_lo_u32 v23, v23, s99
  v_add_u32 v23, s96, v23
  v_add_u32 v24, s99, v23
  v_cndmask_b32 v25, v23, v25, vcc
  v_cndmask_b32 v26, v24, v26, vcc
  v_min_u32 v26, s97, v26
  s_sub_u32 s76, s61, s28
  s_add_u32 s76, s76, s96
  s_mov_b32 s75, s28
  v_cmp_gt_u32 s[4:5], s75, v25
  v_cmp_gt_u32 s[6:7], s76, v25
  v_cmp_lt_u32 s[8:9], s96, v26
  s_mov_b32 s73, 0
  s_and_b64 s[6:7], s[6:7], s[8:9]
  s_or_b64 s[4:5], s[4:5], s[6:7]
  v_cmp_lt_u32 s[6:7], s75, v26
  v_cmp_lt_u32 s[8:9], s76, v26
  s_add_u32 s75, s75, s29
  s_add_u32 s76, s76, s62
  s_sub_u32 s76, s76, s29
  v_cmp_gt_u32 s[10:11], s75, v25
  v_cmp_gt_u32 s[12:13], s76, v25
  s_and_b64 s[6:7], s[6:7], s[10:11]
  s_and_b64 s[8:9], s[8:9], s[12:13]
  s_or_b64 s[6:7], s[6:7], s[8:9]
  s_or_b64 s[84:85], s[6:7], s[4:5]
  s_bitcmp1_b64 s[84:85], s54
  s_cselect_b32 s77, 1, 0
  s_or_b32 s73, s73, s77
  v_cmp_lt_u32 s[6:7], s75, v26
  v_cmp_lt_u32 s[8:9], s76, v26
  s_add_u32 s75, s75, s30
  s_add_u32 s76, s76, s63
  s_sub_u32 s76, s76, s30
  v_cmp_gt_u32 s[10:11], s75, v25
  v_cmp_gt_u32 s[12:13], s76, v25
  s_and_b64 s[6:7], s[6:7], s[10:11]
  s_and_b64 s[8:9], s[8:9], s[12:13]
  s_or_b64 s[6:7], s[6:7], s[8:9]
  s_or_b64 s[86:87], s[6:7], s[4:5]
  s_bitcmp1_b64 s[86:87], s54
  s_cselect_b32 s77, 2, 0
  s_or_b32 s73, s73, s77
  v_cmp_lt_u32 s[6:7], s75, v26
  v_cmp_lt_u32 s[8:9], s76, v26
  s_add_u32 s75, s75, s31
  s_add_u32 s76, s76, s64
  s_sub_u32 s76, s76, s31
  v_cmp_gt_u32 s[10:11], s75, v25
  v_cmp_gt_u32 s[12:13], s76, v25
  s_and_b64 s[6:7], s[6:7], s[10:11]
  s_and_b64 s[8:9], s[8:9], s[12:13]
  s_or_b64 s[6:7], s[6:7], s[8:9]
  s_or_b64 s[88:89], s[6:7], s[4:5]
  s_bitcmp1_b64 s[88:89], s54
  s_cselect_b32 s77, 4, 0
  s_or_b32 s73, s73, s77
  v_cmp_lt_u32 s[6:7], s75, v26
  v_cmp_lt_u32 s[8:9], s76, v26
  s_add_u32 s75, s75, s98
  s_add_u32 s76, s76, s65
  s_sub_u32 s76, s76, s98
  v_cmp_gt_u32 s[10:11], s75, v25
  v_cmp_gt_u32 s[12:13], s76, v25
  s_and_b64 s[6:7], s[6:7], s[10:11]
  s_and_b64 s[8:9], s[8:9], s[12:13]
  s_or_b64 s[6:7], s[6:7], s[8:9]
  s_or_b64 s[90:91], s[6:7], s[4:5]
  s_bitcmp1_b64 s[90:91], s54
  s_cselect_b32 s77, 8, 0
  s_or_b32 s73, s73, s77
  s_lshl_b32 s67, s53, 6
  s_add_u32 s67, s67, s54
  s_lshl_b32 s66, s67, 14
  s_lshl_b32 s67, s67, 10
  s_add_u32 s67, s67, 0x400000
  s_lshr_b32 s72, s54, 2
  s_lshl_b32 s72, s72, 1
  s_and_b32 s75, s54, 1
  s_or_b32 s72, s72, s75
  s_lshr_b32 s74, s54, 4
  s_cmp_eq_u32 s74, 0
  s_cselect_b64 s[32:33], s[84:85], s[86:87]
  s_cmp_eq_u32 s74, 2
  s_cselect_b64 s[32:33], s[88:89], s[32:33]
  s_cmp_eq_u32 s74, 3
  s_cselect_b64 s[32:33], s[90:91], s[32:33]
  s_cmp_eq_u32 s52, 4
  s_cbranch_scc1 L_help
  v_mov_b32 v19, 0xd3800000
  v_mov_b32 v21, 0
  v_mul_f32 v20, s57, v19
  v_mov_b32 v52, 0
  v_mov_b32 v53, 0
  v_mov_b32 v54, 0
  v_mov_b32 v55, 0
  v_mov_b32 v56, 0
  v_mov_b32 v57, 0
  v_mov_b32 v58, 0
  v_mov_b32 v59, 0
  v_mov_b32 v60, 0
  v_mov_b32 v61, 0
  v_mov_b32 v62, 0
  v_mov_b32 v63, 0
  v_mov_b32 v64, 0
  v_mov_b32 v65, 0
  v_mov_b32 v66, 0
  v_mov_b32 v67, 0
  v_mov_b32 v68, 0
  v_mov_b32 v69, 0
  v_mov_b32 v70, 0
  v_mov_b32 v71, 0
  v_mov_b32 v72, 0
  v_mov_b32 v73, 0
  v_mov_b32 v74, 0
  v_mov_b32 v75, 0
  v_mov_b32 v76, 0
  v_mov_b32 v77, 0
  v_mov_b32 v78, 0
  v_mov_b32 v79, 0
  v_mov_b32 v80, 0
  v_mov_b32 v81, 0
  v_mov_b32 v82, 0
  v_mov_b32 v83, 0
  v_lshrrev_b32 v25, 2, v3
  v_mov_b32 v18, s48
  v_mov_b32 v26, s49
  v_mov_b32 v27, s50
  v_mov_b32 v28, s51
  v_cmp_eq_u32 s[4:5], 1, v25
  v_cmp_eq_u32 s[6:7], 2, v25
  v_cmp_eq_u32 s[8:9], 3, v25
  v_lshlrev_b32 v24, 2, v2
  v_cndmask_b32 v18, v18, v26, s[4:5]
  v_cndmask_b32 v18, v18, v27, s[6:7]
  v_cndmask_b32 v18, v18, v28, s[8:9]
  v_sub_u32 v18, v18, v24
  v_and_b32 v23, 7, v3
  v_xor_b32 v23, v23, v2
  v_lshlrev_b32 v29, 9, v3
  v_lshl_add_u32 v29, v23, 4, v29
  v_add_u32 v29, s60, v29
  v_xor_b32 v30, 64, v29
  v_and_b32 v23, 12, v3
  v_and_b32 v24, 1, v3
  v_bfe_u32 v26, v3, 1, 1
  v_lshl_add_u32 v24, v24, 1, v26
  v_add_u32 v23, v23, v24
  s_lshl_b32 s75, s52, 7
  v_lshl_add_u32 v31, v23, 3, s75
  s_lshl_b32 s75, s55, 13
  s_lshl_b32 s76, s56, 11
  s_add_u32 s76, s76, s75
  s_lshl_b32 s77, s55, 7
  s_lshl_b32 s78, s56, 5
  s_add_u32 s78, s77, s78
  s_lshl_b32 s75, s56, 2
  v_lshl_add_u32 v35, v24, 3, s78
  v_lshrrev_b32 v23, 5, v1
  v_and_b32 v24, 31, v1
  v_lshl_add_u32 v34, v23, 4, s78
  v_add_u32 v26, s75, v23
  v_xor_b32 v26, v26, v24
  v_lshlrev_b32 v26, 4, v26
  v_lshl_add_u32 v26, v23, 9, v26
  v_add_u32 v32, s76, v26
  v_xor_b32 v33, 32, v32
  s_lshl_b32 s75, s55, 11
  s_lshl_b32 s76, s56, 12
  s_add_u32 s75, s75, s76
  s_add_u32 s66, s66, s75
  s_add_u32 s35, s66, 0x2000
  s_lshl_b32 s76, s56, 8
  s_add_u32 s67, s67, s76
  s_add_u32 s67, s67, s77
  s_lshr_b32 s73, s73, s56
  s_cmp_lg_u32 s68, 0
  s_cbranch_scc1 L_zq
L_noz:
  s_mov_b32 s71, 0
  s_mov_b32 s77, 0x5000000
  s_cmp_eq_u32 s70, 0
  s_cbranch_scc1 L_notile
L_loop:
  s_add_u32 s81, s71, 1
  v_readlane_b32 s79, v16, s71
  v_readlane_b32 s80, v17, s71
  v_readlane_b32 s78, v17, s81
  v_readlane_b32 s75, v14, s81
  v_readlane_b32 s76, v15, s81
  s_mov_b32 s71, s81
  s_lshr_b32 s81, s79, 16
  s_lshr_b32 s82, s80, 16
  s_and_b32 s79, s79, 0xffff
  s_and_b32 s80, s80, 0xffff
  s_mul_i32 s4, s81, 0x10001
  s_mul_i32 s6, s82, 0x10001
  s_mov_b32 s5, s4
  s_mov_b32 s7, s6
  v_subrev_u32 v23, s79, v18
  v_subrev_u32 v24, s80, v18
  v_cndmask_b32 v23, 0, v23, s[4:5]
  v_cndmask_b32 v24, 0, v24, s[6:7]
  s_cmp_ge_u32 s78, 0x10000
  s_cselect_b32 s78, 0x5000000, 0
  v_cmp_lt_i32 s[4:5], 0, v23
  v_cmp_lt_i32 s[6:7], 1, v23
  v_cmp_lt_i32 s[8:9], 2, v23
  v_cmp_lt_i32 s[10:11], 3, v23
  v_cmp_lt_i32 s[12:13], 0, v24
  v_cmp_lt_i32 s[14:15], 1, v24
  v_cmp_lt_i32 s[16:17], 2, v24
  v_cmp_lt_i32 s[18:19], 3, v24
  s_cmp_ge_u32 s71, s70
  s_waitcnt vmcnt(8)
  ds_read_b128 v[84:87], v10 offset:0
  ds_read_b128 v[88:91], v11 offset:0
  ds_read_b128 v[92:95], v12 offset:0
  ds_read_b128 v[96:99], v13 offset:0
  ds_read_b128 v[100:103], v10 offset:4096
  ds_read_b128 v[104:107], v11 offset:4096
  ds_read_b128 v[108:111], v12 offset:4096
  ds_read_b128 v[112:115], v13 offset:4096
  s_waitcnt lgkmcnt(4)
  v_mfma_f32_16x16x32_bf16 v[116:119], v[84:87], v[36:39], 0
  v_mfma_f32_16x16x32_bf16 v[116:119], v[88:91], v[40:43], v[116:119]
  v_mfma_f32_16x16x32_bf16 v[116:119], v[92:95], v[44:47], v[116:119]
  v_mfma_f32_16x16x32_bf16 v[116:119], v[96:99], v[48:51], v[116:119]
  s_waitcnt lgkmcnt(0)
  v_mfma_f32_16x16x32_bf16 v[120:123], v[100:103], v[36:39], 0
  v_mfma_f32_16x16x32_bf16 v[120:123], v[104:107], v[40:43], v[120:123]
  v_mfma_f32_16x16x32_bf16 v[120:123], v[108:111], v[44:47], v[120:123]
  v_mfma_f32_16x16x32_bf16 v[120:123], v[112:115], v[48:51], v[120:123]
  s_cbranch_scc1 L_nok
  s_add_u32 m0, s60, 0
  s_mov_b32 s22, s77
  buffer_load_dwordx4 v4, s[20:23], s75 offen offset:0 nt lds
  buffer_load_dwordx4 v5, s[20:23], s75 offen offset:1024 nt lds
  buffer_load_dwordx4 v6, s[20:23], s75 offen offset:2048 nt lds
  buffer_load_dwordx4 v7, s[20:23], s75 offen offset:3072 nt lds
  s_add_u32 m0, s60, 4096
  s_mov_b32 s22, s78
  buffer_load_dwordx4 v4, s[20:23], s76 offen offset:0 nt lds
  buffer_load_dwordx4 v5, s[20:23], s76 offen offset:1024 nt lds
  buffer_load_dwordx4 v6, s[20:23], s76 offen offset:2048 nt lds
  buffer_load_dwordx4 v7, s[20:23], s76 offen offset:3072 nt lds
  s_cmp_ge_u32 s71, s70
L_nok:
  s_nop 2
  v_cndmask_b32 v116, v19, v116, s[4:5]
  v_cndmask_b32 v117, v19, v117, s[6:7]
  v_cndmask_b32 v118, v19, v118, s[8:9]
  v_cndmask_b32 v119, v19, v119, s[10:11]
  v_cndmask_b32 v120, v19, v120, s[12:13]
  v_cndmask_b32 v121, v19, v121, s[14:15]
  v_cndmask_b32 v122, v19, v122, s[16:17]
  v_cndmask_b32 v123, v19, v123, s[18:19]
  v_max3_f32 v23, v116, v117, v118
  v_max3_f32 v24, v119, v120, v121
  v_max3_f32 v23, v23, v122, v123
  v_max_f32 v23, v23, v24
  v_mov_b32 v24, v23
  s_nop 1
  v_permlane32_swap_b32 v23, v24
  v_max_f32 v23, v23, v24
  v_mov_b32 v24, v23
  s_nop 1
  v_permlane16_swap_b32 v23, v24
  v_max_f32 v23, v23, v24
  v_mul_f32 v23, s57, v23
  v_max_f32 v23, v23, v20
  v_sub_f32 v24, v20, v23
  v_mov_b32 v20, v23
  v_exp_f32 v24, v24
  v_fma_f32 v116, v116, s57, -v23
  v_fma_f32 v117, v117, s57, -v23
  v_fma_f32 v118, v118, s57, -v23
  v_fma_f32 v119, v119, s57, -v23
  v_fma_f32 v120, v120, s57, -v23
  v_fma_f32 v121, v121, s57, -v23
  v_fma_f32 v122, v122, s57, -v23
  v_fma_f32 v123, v123, s57, -v23
  v_exp_f32 v116, v116
  v_exp_f32 v117, v117
  v_exp_f32 v118, v118
  v_exp_f32 v119, v119
  v_exp_f32 v120, v120
  v_exp_f32 v121, v121
  v_exp_f32 v122, v122
  v_exp_f32 v123, v123
  v_cmp_neq_f32 vcc, 1.0, v24
  v_add_f32 v25, v116, v117
  v_add_f32 v26, v118, v119
  v_add_f32 v27, v120, v121
  v_add_f32 v28, v122, v123
  v_add_f32 v25, v25, v26
  v_add_f32 v27, v27, v28
  v_add_f32 v25, v25, v27
  v_fma_f32 v21, v21, v24, v25
  v_cvt_pk_bf16_f32 v124, v116, v117
  v_cvt_pk_bf16_f32 v125, v118, v119
  v_cvt_pk_bf16_f32 v126, v120, v121
  v_cvt_pk_bf16_f32 v127, v122, v123
  s_cbranch_vccz L_nors
  v_mul_f32 v52, v24, v52
  v_mul_f32 v53, v24, v53
  v_mul_f32 v54, v24, v54
  v_mul_f32 v55, v24, v55
  v_mul_f32 v56, v24, v56
  v_mul_f32 v57, v24, v57
  v_mul_f32 v58, v24, v58
  v_mul_f32 v59, v24, v59
  v_mul_f32 v60, v24, v60
  v_mul_f32 v61, v24, v61
  v_mul_f32 v62, v24, v62
  v_mul_f32 v63, v24, v63
  v_mul_f32 v64, v24, v64
  v_mul_f32 v65, v24, v65
  v_mul_f32 v66, v24, v66
  v_mul_f32 v67, v24, v67
  v_mul_f32 v68, v24, v68
  v_mul_f32 v69, v24, v69
  v_mul_f32 v70, v24, v70
  v_mul_f32 v71, v24, v71
  v_mul_f32 v72, v24, v72
  v_mul_f32 v73, v24, v73
  v_mul_f32 v74, v24, v74
  v_mul_f32 v75, v24, v75
  v_mul_f32 v76, v24, v76
  v_mul_f32 v77, v24, v77
  v_mul_f32 v78, v24, v78
  v_mul_f32 v79, v24, v79
  v_mul_f32 v80, v24, v80
  v_mul_f32 v81, v24, v81
  v_mul_f32 v82, v24, v82
  v_mul_f32 v83, v24, v83
L_nors:
  s_cbranch_scc0 L_wv
  v_mov_b32 v24, v21
  v_mov_b32 v116, v20
  s_nop 0
  v_permlane32_swap_b32 v21, v24
  v_add_f32 v21, v21, v24
  v_mov_b32 v24, v21
  s_nop 1
  v_permlane16_swap_b32 v21, v24
  v_add_f32 v117, v21, v24
  ds_write_b64 v31, v[116:117] offset:32768
  s_waitcnt vmcnt(0)
L_wv:
  s_waitcnt vmcnt(8)
  v_perm_b32 v128, v140, v136, s58
  v_perm_b32 v129, v148, v144, s58
  v_perm_b32 v130, v156, v152, s58
  v_perm_b32 v131, v164, v160, s58
  v_perm_b32 v132, v140, v136, s59
  v_perm_b32 v133, v148, v144, s59
  v_perm_b32 v134, v156, v152, s59
  v_perm_b32 v135, v164, v160, s59
  v_mfma_f32_16x16x32_bf16 v[52:55], v[128:131], v[124:127], v[52:55]
  v_perm_b32 v128, v141, v137, s58
  v_perm_b32 v129, v149, v145, s58
  v_perm_b32 v130, v157, v153, s58
  v_perm_b32 v131, v165, v161, s58
  v_mfma_f32_16x16x32_bf16 v[56:59], v[132:135], v[124:127], v[56:59]
  v_perm_b32 v132, v141, v137, s59
  v_perm_b32 v133, v149, v145, s59
  v_perm_b32 v134, v157, v153, s59
  v_perm_b32 v135, v165, v161, s59
  v_mfma_f32_16x16x32_bf16 v[60:63], v[128:131], v[124:127], v[60:63]
  v_perm_b32 v128, v142, v138, s58
  v_perm_b32 v129, v150, v146, s58
  v_perm_b32 v130, v158, v154, s58
  v_perm_b32 v131, v166, v162, s58
  v_mfma_f32_16x16x32_bf16 v[64:67], v[132:135], v[124:127], v[64:67]
  v_perm_b32 v132, v142, v138, s59
  v_perm_b32 v133, v150, v146, s59
  v_perm_b32 v134, v158, v154, s59
  v_perm_b32 v135, v166, v162, s59
  v_mfma_f32_16x16x32_bf16 v[68:71], v[128:131], v[124:127], v[68:71]
  v_perm_b32 v128, v143, v139, s58
  v_perm_b32 v129, v151, v147, s58
  v_perm_b32 v130, v159, v155, s58
  v_perm_b32 v131, v167, v163, s58
  v_mfma_f32_16x16x32_bf16 v[72:75], v[132:135], v[124:127], v[72:75]
  v_perm_b32 v132, v143, v139, s59
  v_perm_b32 v133, v151, v147, s59
  v_perm_b32 v134, v159, v155, s59
  v_perm_b32 v135, v167, v163, s59
  v_mfma_f32_16x16x32_bf16 v[76:79], v[128:131], v[124:127], v[76:79]
  s_nop 0
  v_mfma_f32_16x16x32_bf16 v[80:83], v[132:135], v[124:127], v[80:83]
  s_cbranch_scc1 L_loopdone
  s_mov_b32 s26, s77
  buffer_load_dwordx4 v[136:139], v8, s[24:27], s75 offen offset:0 nt
  buffer_load_dwordx4 v[140:143], v8, s[24:27], s75 offen offset:2048 nt
  buffer_load_dwordx4 v[144:147], v9, s[24:27], s75 offen offset:0 nt
  buffer_load_dwordx4 v[148:151], v9, s[24:27], s75 offen offset:2048 nt
  s_mov_b32 s26, s78
  buffer_load_dwordx4 v[152:155], v8, s[24:27], s76 offen offset:0 nt
  buffer_load_dwordx4 v[156:159], v8, s[24:27], s76 offen offset:2048 nt
  buffer_load_dwordx4 v[160:163], v9, s[24:27], s76 offen offset:0 nt
  buffer_load_dwordx4 v[164:167], v9, s[24:27], s76 offen offset:2048 nt
  s_branch L_loop
L_loopdone:
  ds_write_b128 v29, v[52:55] offset:0
  ds_write_b128 v30, v[56:59] offset:0
  ds_write_b128 v29, v[60:63] offset:128
  ds_write_b128 v30, v[64:67] offset:128
  ds_write_b128 v29, v[68:71] offset:256
  ds_write_b128 v30, v[72:75] offset:256
  s_nop 1
  ds_write_b128 v29, v[76:79] offset:384
  ds_write_b128 v30, v[80:83] offset:384
  v_mov_b32 v23, 0
  v_lshlrev_b32 v4, 4, v1
  s_waitcnt lgkmcnt(0)
  s_barrier
  s_bitcmp1_b32 s73, 0
  s_cbranch_scc0 L_nr0
  ds_read_b128 v[84:87], v34 offset:32768
  ds_read_b128 v[88:91], v34 offset:33024
  ds_read_b128 v[136:139], v32 offset:0
  ds_read_b128 v[140:143], v33 offset:1024
  ds_read_b128 v[144:147], v32 offset:16384
  ds_read_b128 v[148:151], v33 offset:17408
L_nr0:
  s_bitcmp1_b32 s73, 2
  s_cbranch_scc0 L_nr1
  ds_read_b128 v[92:95], v34 offset:32832
  ds_read_b128 v[96:99], v34 offset:33088
  ds_read_b128 v[152:155], v32 offset:4096
  ds_read_b128 v[156:159], v33 offset:5120
  ds_read_b128 v[160:163], v32 offset:20480
  ds_read_b128 v[164:167], v33 offset:21504
L_nr1:
  s_bitcmp1_b32 s73, 0
  s_cbranch_scc0 L_nm0
  s_waitcnt lgkmcnt(0)
  v_max_f32 v25, v84, v88
  v_max_f32 v26, v86, v90
  v_sub_f32 v84, v84, v25
  v_sub_f32 v86, v86, v26
  v_sub_f32 v88, v88, v25
  v_sub_f32 v90, v90, v26
  v_exp_f32 v84, v84
  v_exp_f32 v86, v86
  v_exp_f32 v88, v88
  v_exp_f32 v90, v90
  ds_read_b64 v[116:117], v35 offset:32768
  ds_read_b64 v[118:119], v35 offset:33024
  v_mul_f32 v52, v84, v136
  v_mul_f32 v53, v84, v137
  v_mul_f32 v54, v84, v138
  v_mul_f32 v55, v84, v139
  v_fmac_f32 v52, v88, v144
  v_fmac_f32 v53, v88, v145
  v_fmac_f32 v54, v88, v146
  v_fmac_f32 v55, v88, v147
  buffer_store_dwordx4 v[52:55], v4, s[36:39], s66 offen offset:0 sc1
  v_mul_f32 v56, v86, v140
  v_mul_f32 v57, v86, v141
  v_mul_f32 v58, v86, v142
  v_mul_f32 v59, v86, v143
  v_fmac_f32 v56, v90, v148
  v_fmac_f32 v57, v90, v149
  v_fmac_f32 v58, v90, v150
  v_fmac_f32 v59, v90, v151
  buffer_store_dwordx4 v[56:59], v4, s[36:39], s66 offen offset:1024 sc1
L_nm0:
  s_bitcmp1_b32 s73, 2
  s_cbranch_scc0 L_nm1
  s_waitcnt lgkmcnt(0)
  v_max_f32 v25, v92, v96
  v_max_f32 v26, v94, v98
  v_sub_f32 v92, v92, v25
  v_sub_f32 v94, v94, v26
  v_sub_f32 v96, v96, v25
  v_sub_f32 v98, v98, v26
  v_exp_f32 v92, v92
  v_exp_f32 v94, v94
  v_exp_f32 v96, v96
  v_exp_f32 v98, v98
  ds_read_b64 v[120:121], v35 offset:32832
  ds_read_b64 v[122:123], v35 offset:33088
  v_mul_f32 v60, v92, v152
  v_mul_f32 v61, v92, v153
  v_mul_f32 v62, v92, v154
  v_mul_f32 v63, v92, v155
  v_fmac_f32 v60, v96, v160
  v_fmac_f32 v61, v96, v161
  v_fmac_f32 v62, v96, v162
  v_fmac_f32 v63, v96, v163
  buffer_store_dwordx4 v[60:63], v4, s[36:39], s35 offen offset:0 sc1
  v_mul_f32 v64, v94, v156
  v_mul_f32 v65, v94, v157
  v_mul_f32 v66, v94, v158
  v_mul_f32 v67, v94, v159
  v_fmac_f32 v64, v98, v164
  v_fmac_f32 v65, v98, v165
  v_fmac_f32 v66, v98, v166
  v_fmac_f32 v67, v98, v167
  buffer_store_dwordx4 v[64:67], v4, s[36:39], s35 offen offset:1024 sc1
L_nm1:
  ds_read_b64 v[134:135], v23 offset:33296
  s_lshl_b32 s75, s72, 9
  s_lshl_b32 s78, s52, 7
  s_add_u32 s61, s75, s78
  s_lshl_b32 s78, s53, 20
  s_add_u32 s61, s61, s78
  v_lshrrev_b32 v23, 3, v1
  v_and_b32 v24, 7, v1
  v_lshlrev_b32 v8, 14, v23
  v_lshl_add_u32 v8, v24, 4, v8
  v_lshlrev_b32 v9, 2, v23
  v_lshrrev_b32 v27, v23, s32
  v_lshrrev_b32 v28, v23, s33
  s_waitcnt lgkmcnt(0)
  v_max_f32 v68, v116, v118
  v_sub_f32 v116, v116, v68
  v_sub_f32 v118, v118, v68
  v_exp_f32 v116, v116
  v_exp_f32 v118, v118
  v_mov_b32 v69, v134
  v_mov_b32 v71, v135
  v_mul_f32 v70, v116, v117
  v_fmac_f32 v70, v118, v119
  v_max_f32 v72, v120, v122
  v_sub_f32 v120, v120, v72
  v_sub_f32 v122, v122, v72
  v_exp_f32 v120, v120
  v_exp_f32 v122, v122
  v_mov_b32 v73, v134
  v_mov_b32 v75, v135
  v_mul_f32 v74, v120, v121
  v_fmac_f32 v74, v122, v123
  v_and_b32 v25, 0x1, v27
  v_cmp_ne_u32 s[4:5], 0, v25
  v_and_b32 v26, 0x100, v27
  v_cmp_ne_u32 s[6:7], 0, v26
  v_and_b32 v25, 0x10000, v27
  v_cmp_ne_u32 s[8:9], 0, v25
  v_and_b32 v26, 0x1000000, v27
  v_cmp_ne_u32 s[10:11], 0, v26
  v_and_b32 v25, 0x1, v28
  v_cmp_ne_u32 s[12:13], 0, v25
  v_and_b32 v26, 0x100, v28
  v_cmp_ne_u32 s[14:15], 0, v26
  v_and_b32 v25, 0x10000, v28
  v_cmp_ne_u32 s[16:17], 0, v25
  v_and_b32 v26, 0x1000000, v28
  v_cmp_ne_u32 s[18:19], 0, v26
  v_and_b32 v25, 3, v1
  v_bfe_u32 v26, v1, 2, 1
  v_lshlrev_b32 v14, 5, v25
  v_lshl_add_u32 v14, v2, 3, v14
  v_add_u32 v14, v26, v14
  s_lshl_b32 s78, s52, 1
  v_add_u32 v14, s78, v14
  v_lshlrev_b32 v14, 1, v14
  s_lshl_b32 s76, s74, 5
  s_lshl_b32 s77, s53, 3
  s_add_u32 s76, s76, s77
  s_and_b32 s77, s72, 7
  s_add_u32 s76, s76, s77
  s_lshl_b32 s76, s76, 8
  s_mov_b64 exec, 0xff
  s_waitcnt vmcnt(0)
  s_bitcmp1_b32 s73, 0
  s_cbranch_scc0 L_nl0
  buffer_store_dwordx4 v[68:71], v4, s[36:39], s67 offen offset:0 sc1
L_nl0:
  s_bitcmp1_b32 s73, 2
  s_cbranch_scc0 L_nl1
  buffer_store_dwordx4 v[72:75], v4, s[36:39], s67 offen offset:512 sc1
L_nl1:
  s_mov_b64 exec, -1
  s_bitcmp1_b32 s54, 1
  s_cbranch_scc0 L_fin
  v_mov_b32 v36, 0
  v_mov_b32 v37, 0
  v_mov_b32 v38, 0
  v_mov_b32 v39, 0
  v_mov_b32 v40, 0
  v_mov_b32 v41, 0
  v_mov_b32 v42, 0
  v_mov_b32 v43, 0
  v_mov_b32 v44, 0
  v_mov_b32 v45, 0
  v_mov_b32 v46, 0
  v_mov_b32 v47, 0
  v_mov_b32 v48, 0
  v_mov_b32 v49, 0
  v_mov_b32 v50, 0
  v_mov_b32 v51, 0
  v_mov_b32 v100, 0
  v_mov_b32 v101, 0
  v_mov_b32 v102, 0
  v_mov_b32 v103, 0
  v_mov_b32 v104, 0
  v_mov_b32 v105, 0
  v_mov_b32 v106, 0
  v_mov_b32 v107, 0
  v_mov_b32 v108, 0
  v_mov_b32 v109, 0
  v_mov_b32 v110, 0
  v_mov_b32 v111, 0
  v_mov_b32 v112, 0
  v_mov_b32 v113, 0
  v_mov_b32 v114, 0
  v_mov_b32 v115, 0
  s_barrier
  s_mov_b64 exec, s[4:5]
  s_cbranch_execz L_sk0
  buffer_load_dwordx4 v[36:39], v8, s[36:39], s61 offen sc1
L_sk0:
  s_add_u32 s61, s61, 0x20000
  s_mov_b64 exec, s[6:7]
  s_cbranch_execz L_sk1
  buffer_load_dwordx4 v[40:43], v8, s[36:39], s61 offen sc1
L_sk1:
  s_add_u32 s61, s61, 0x20000
  s_mov_b64 exec, s[8:9]
  s_cbranch_execz L_sk2
  buffer_load_dwordx4 v[44:47], v8, s[36:39], s61 offen sc1
L_sk2:
  s_add_u32 s61, s61, 0x20000
  s_mov_b64 exec, s[10:11]
  s_cbranch_execz L_sk3
  buffer_load_dwordx4 v[48:51], v8, s[36:39], s61 offen sc1
L_sk3:
  s_add_u32 s61, s61, 0x20000
  s_mov_b64 exec, s[12:13]
  s_cbranch_execz L_sk4
  buffer_load_dwordx4 v[100:103], v8, s[36:39], s61 offen sc1
L_sk4:
  s_add_u32 s61, s61, 0x20000
  s_mov_b64 exec, s[14:15]
  s_cbranch_execz L_sk5
  buffer_load_dwordx4 v[104:107], v8, s[36:39], s61 offen sc1
L_sk5:
  s_add_u32 s61, s61, 0x20000
  s_mov_b64 exec, s[16:17]
  s_cbranch_execz L_sk6
  buffer_load_dwordx4 v[108:111], v8, s[36:39], s61 offen sc1
L_sk6:
  s_add_u32 s61, s61, 0x20000
  s_mov_b64 exec, s[18:19]
  s_cbranch_execz L_sk7
  buffer_load_dwordx4 v[112:115], v8, s[36:39], s61 offen sc1
L_sk7:
  s_mov_b64 exec, -1
  s_barrier
  ds_read_b32 v136, v9 offset:33344
  ds_read_b32 v138, v9 offset:33376
  ds_read_b32 v140, v9 offset:33408
  ds_read_b32 v142, v9 offset:33440
  ds_read_b32 v144, v9 offset:33472
  ds_read_b32 v146, v9 offset:33504
  ds_read_b32 v148, v9 offset:33536
  ds_read_b32 v150, v9 offset:33568
  s_waitcnt vmcnt(0) lgkmcnt(0)
  v_pk_mul_f32 v[52:53], v[136:137], v[36:37] op_sel_hi:[0,1]
  v_pk_mul_f32 v[54:55], v[136:137], v[38:39] op_sel_hi:[0,1]
  v_pk_mul_f32 v[56:57], v[138:139], v[40:41] op_sel_hi:[0,1]
  v_pk_mul_f32 v[58:59], v[138:139], v[42:43] op_sel_hi:[0,1]
  v_pk_fma_f32 v[52:53], v[140:141], v[44:45], v[52:53] op_sel_hi:[0,1,1]
  v_pk_fma_f32 v[54:55], v[140:141], v[46:47], v[54:55] op_sel_hi:[0,1,1]
  v_pk_fma_f32 v[56:57], v[142:143], v[48:49], v[56:57] op_sel_hi:[0,1,1]
  v_pk_fma_f32 v[58:59], v[142:143], v[50:51], v[58:59] op_sel_hi:[0,1,1]
  v_pk_fma_f32 v[52:53], v[144:145], v[100:101], v[52:53] op_sel_hi:[0,1,1]
  v_pk_fma_f32 v[54:55], v[144:145], v[102:103], v[54:55] op_sel_hi:[0,1,1]
  v_pk_fma_f32 v[56:57], v[146:147], v[104:105], v[56:57] op_sel_hi:[0,1,1]
  v_pk_fma_f32 v[58:59], v[146:147], v[106:107], v[58:59] op_sel_hi:[0,1,1]
  v_pk_fma_f32 v[52:53], v[148:149], v[108:109], v[52:53] op_sel_hi:[0,1,1]
  v_pk_fma_f32 v[54:55], v[148:149], v[110:111], v[54:55] op_sel_hi:[0,1,1]
  v_pk_fma_f32 v[56:57], v[150:151], v[112:113], v[56:57] op_sel_hi:[0,1,1]
  v_pk_fma_f32 v[58:59], v[150:151], v[114:115], v[58:59] op_sel_hi:[0,1,1]
  v_pk_add_f32 v[52:53], v[52:53], v[56:57]
  v_pk_add_f32 v[54:55], v[54:55], v[58:59]
  s_nop 1
  v_permlane32_swap_b32 v52, v54
  v_permlane32_swap_b32 v53, v55
  v_pk_add_f32 v[52:53], v[52:53], v[54:55]
  s_nop 1
  v_permlane16_swap_b32 v52, v53
  v_add_f32 v52, v52, v53
  s_nop 1
  v_add_f32_dpp v52, v52, v52 row_ror:8 row_mask:0xf bank_mask:0xf
  v_cvt_pk_bf16_f32 v28, v52, v52
  s_mov_b32 exec_lo, 0x00ff00ff
  s_mov_b32 exec_hi, 0x00ff00ff
  buffer_store_short v28, v14, s[40:43], s76 offen
L_fin:
L_end:
  s_endpgm
L_mknon:
  s_memrealtime s[92:93]
  v_mov_b32 v25, 0
  s_waitcnt lgkmcnt(0)
  s_mul_i32 s80, s93, 0x9e3779b9
  s_xor_b32 s80, s80, s92
  s_lshl_b32 s81, s92, 1
  s_or_b32 s81, s81, 1
  v_mov_b32 v128, s81
  v_mov_b32 v129, s80
  s_mov_b64 exec, 1
  buffer_store_dwordx2 v[128:129], v25, s[44:47], 0 offen sc1
  s_mov_b64 exec, -1
  s_branch L_nonon
L_rem:
  s_sub_u32 s82, s97, 63
  s_ff1_i32_b32 s100, s95
  s_lshr_b32 s100, s96, s100
  s_sub_u32 s99, 64, s100
  v_cvt_f32_u32 v23, s99
  s_add_u32 s99, s99, s82
  s_sub_u32 s99, s99, s96
  s_lshl_b32 s99, s99, 1
  s_sub_u32 s99, s99, 1
  v_rcp_f32 v23, v23
  v_cvt_f32_u32 v24, s99
  v_mul_f32 v23, 0.5, v23
  v_mul_f32 v23, v23, v24
  v_cvt_u32_f32 v23, v23
  s_nop 0
  v_readfirstlane_b32 s99, v23
  s_sub_u32 s66, s54, s100
  s_mul_i32 s66, s66, s99
  s_add_u32 s66, s66, s96
  s_add_u32 s67, s66, s99
  s_min_u32 s67, s67, s82
  v_add_u32 v23, s66, v17
  v_add_u32 v24, 1, v23
  s_sub_u32 s77, s28, s96
  s_sub_u32 s72, s61, s77
  s_sub_u32 s78, s29, s72
  s_sub_u32 s73, s62, s78
  s_sub_u32 s79, s30, s73
  s_sub_u32 s74, s63, s79
  s_sub_u32 s80, s31, s74
  s_sub_u32 s71, s64, s80
  s_sub_u32 s81, s98, s71
  s_add_u32 s78, s78, s61
  s_add_u32 s79, s79, s61
  s_add_u32 s79, s79, 1024
  s_add_u32 s80, s80, s61
  s_add_u32 s80, s80, 2048
  s_add_u32 s81, s81, s61
  s_add_u32 s81, s81, 3072
  v_mov_b32 v116, 0xf0
  v_mov_b32 v117, 0xf00
  v_mov_b32 v118, 0xf000
  v_mov_b32 v119, 0xffff
  v_cmp_gt_u32 s[4:5], s72, v23
  v_cmp_gt_u32 s[6:7], s73, v23
  v_cmp_gt_u32 s[8:9], s74, v23
  v_cmp_gt_u32 s[10:11], s71, v23
  v_cmp_gt_u32 s[88:89], s67, v23
  v_add_u32 v25, s77, v23
  v_add_u32 v84, s78, v23
  v_add_u32 v85, s79, v23
  v_add_u32 v86, s80, v23
  v_add_u32 v87, s81, v23
  v_cndmask_b32 v25, v84, v25, s[4:5]
  v_cndmask_b32 v25, v85, v25, s[6:7]
  v_cndmask_b32 v25, v86, v25, s[8:9]
  v_cndmask_b32 v25, v87, v25, s[10:11]
  v_cndmask_b32 v25, 0, v25, s[88:89]
  v_lshlrev_b32 v88, 2, v25
  ds_read_b32 v14, v88 offset:33600
  v_cndmask_b32 v27, 15, v119, s[4:5]
  v_cndmask_b32 v27, v116, v27, s[6:7]
  v_cndmask_b32 v27, v117, v27, s[8:9]
  v_cndmask_b32 v27, v118, v27, s[10:11]
  v_cndmask_b32 v27, 0, v27, s[88:89]
  v_cmp_gt_u32 s[12:13], s72, v24
  v_cmp_gt_u32 s[14:15], s73, v24
  v_cmp_gt_u32 s[16:17], s74, v24
  v_cmp_gt_u32 s[18:19], s71, v24
  v_cmp_gt_u32 s[84:85], s67, v24
  v_add_u32 v26, s77, v24
  v_add_u32 v84, s78, v24
  v_add_u32 v85, s79, v24
  v_add_u32 v86, s80, v24
  v_add_u32 v87, s81, v24
  v_cndmask_b32 v26, v84, v26, s[12:13]
  v_cndmask_b32 v26, v85, v26, s[14:15]
  v_cndmask_b32 v26, v86, v26, s[16:17]
  v_cndmask_b32 v26, v87, v26, s[18:19]
  v_cndmask_b32 v26, 0, v26, s[84:85]
  v_lshlrev_b32 v88, 2, v26
  ds_read_b32 v15, v88 offset:33600
  v_cndmask_b32 v28, 15, v119, s[12:13]
  v_cndmask_b32 v28, v116, v28, s[14:15]
  v_cndmask_b32 v28, v117, v28, s[16:17]
  v_cndmask_b32 v28, v118, v28, s[18:19]
  v_cndmask_b32 v28, 0, v28, s[84:85]
  s_branch L_desc
L_zq:
  s_waitcnt vmcnt(16)
  v_mov_b32 v26, s68
  v_lshrrev_b32 v25, v25, v26
  v_and_b32 v25, 1, v25
  v_cmp_eq_u32 vcc, 0, v25
  s_nop 1
  v_cndmask_b32 v36, 0, v36, vcc
  v_cndmask_b32 v37, 0, v37, vcc
  v_cndmask_b32 v38, 0, v38, vcc
  v_cndmask_b32 v39, 0, v39, vcc
  v_cndmask_b32 v40, 0, v40, vcc
  v_cndmask_b32 v41, 0, v41, vcc
  v_cndmask_b32 v42, 0, v42, vcc
  v_cndmask_b32 v43, 0, v43, vcc
  v_cndmask_b32 v44, 0, v44, vcc
  v_cndmask_b32 v45, 0, v45, vcc
  v_cndmask_b32 v46, 0, v46, vcc
  v_cndmask_b32 v47, 0, v47, vcc
  v_cndmask_b32 v48, 0, v48, vcc
  v_cndmask_b32 v49, 0, v49, vcc
  v_cndmask_b32 v50, 0, v50, vcc
  v_cndmask_b32 v51, 0, v51, vcc
  s_nop 1
  s_branch L_noz
L_notile:
  v_mov_b32 v116, v20
  v_mov_b32 v117, 0
  s_waitcnt vmcnt(0)
  ds_write_b64 v31, v[116:117] offset:32768
  s_branch L_loopdone
L_help:
  s_mov_b32 s94, 0x40000
  v_mov_b32 v25, 0
L_non:
  s_sleep 24
  buffer_load_dwordx2 v[132:133], v25, s[44:47], 0 offen sc1
  s_sub_u32 s94, s94, 1
  s_cmp_eq_u32 s94, 0
  s_cbranch_scc1 L_nond
  s_waitcnt vmcnt(0)
  v_cmp_eq_u32 vcc, 0, v132
  s_cbranch_vccnz L_non
L_nond:
  ds_write_b64 v25, v[132:133] offset:33296
  s_lshr_b32 s75, s72, 2
  s_lshl_b32 s75, s75, 7
  s_and_b32 s76, s72, 3
  s_lshl_b32 s76, s76, 4
  s_lshl_b32 s34, s53, 16
  s_add_u32 s34, s34, s75
  s_add_u32 s34, s34, s76
  s_add_u32 s34, s34, 0x400000
  v_lshlrev_b32 v27, 10, v1
  v_lshlrev_b32 v28, 2, v1
  v_mov_b32 v128, 0xfe800000
  v_mov_b32 v130, 0
  s_mov_b64 s[4:5], s[32:33]
  s_bitcmp1_b32 s54, 1
  s_waitcnt lgkmcnt(0)
  s_barrier
  s_cbranch_scc0 L_fin
L_poll:
  s_mov_b64 exec, s[4:5]
  buffer_load_dwordx4 v[128:131], v27, s[36:39], s34 offen sc1
  s_sub_u32 s94, s94, 1
  s_cmp_eq_u32 s94, 0
  s_cbranch_scc1 L_polld
  s_waitcnt vmcnt(0)
  v_cmp_ne_u32 vcc, v129, v132
  v_cmp_ne_u32 s[4:5], v131, v133
  s_nop 0
  s_or_b64 s[4:5], s[4:5], vcc
  s_cbranch_scc0 L_polld
  s_bcnt1_i32_b64 s75, s[4:5]
  s_sleep 1
  s_cmp_le_u32 s75, 3
  s_cbranch_scc1 L_poll
  s_sleep 6
  s_cmp_le_u32 s75, 10
  s_cbranch_scc1 L_poll
  s_sleep 20
  s_branch L_poll
L_polld:
  s_barrier
  s_mov_b64 exec, -1
  v_mov_b32 v23, v128
  s_nop 1
  v_max_f32_dpp v23, v23, v23 row_ror:8 row_mask:0xf bank_mask:0xf
  s_nop 1
  v_max_f32_dpp v23, v23, v23 row_ror:4 row_mask:0xf bank_mask:0xf
  s_nop 1
  v_max_f32_dpp v23, v23, v23 row_ror:2 row_mask:0xf bank_mask:0xf
  s_nop 1
  v_max_f32_dpp v23, v23, v23 row_ror:1 row_mask:0xf bank_mask:0xf
  v_mov_b32 v24, v23
  s_nop 1
  v_permlane16_swap_b32 v23, v24
  v_max_f32 v23, v23, v24
  v_mov_b32 v24, v23
  s_nop 1
  v_permlane32_swap_b32 v23, v24
  v_max_f32 v23, v23, v24
  v_sub_f32 v23, v128, v23
  v_exp_f32 v23, v23
  s_nop 0
  v_mul_f32 v25, v23, v130
  s_nop 1
  v_add_f32_dpp v25, v25, v25 row_ror:8 row_mask:0xf bank_mask:0xf
  s_nop 1
  v_add_f32_dpp v25, v25, v25 row_ror:4 row_mask:0xf bank_mask:0xf
  s_nop 1
  v_add_f32_dpp v25, v25, v25 row_ror:2 row_mask:0xf bank_mask:0xf
  s_nop 1
  v_add_f32_dpp v25, v25, v25 row_ror:1 row_mask:0xf bank_mask:0xf
  v_mov_b32 v24, v25
  s_nop 1
  v_permlane16_swap_b32 v25, v24
  v_add_f32 v25, v25, v24
  v_mov_b32 v24, v25
  s_nop 1
  v_permlane32_swap_b32 v25, v24
  v_add_f32 v25, v25, v24
  v_rcp_f32 v25, v25
  s_nop 0
  v_mul_f32 v23, v23, v25
  ds_write_b32 v28, v23 offset:33344
  s_waitcnt lgkmcnt(0)
  s_barrier
  s_branch L_fin
L_codeend:
.section .rodata,"a"
.p2align 6
.amdhsa_kernel standalone__paged_block_table_kv_radixattention__decode_kernel
  .amdhsa_next_free_vgpr 168
  .amdhsa_next_free_sgpr 102
  .amdhsa_accum_offset 168
  .amdhsa_group_segment_fixed_size 0
  .amdhsa_kernarg_size 64
  .amdhsa_user_sgpr_count 2
  .amdhsa_user_sgpr_kernarg_segment_ptr 1
  .amdhsa_system_sgpr_workgroup_id_x 1
.end_amdhsa_kernel
```
